```python
import torch

def _softmax(x, axis=-1):
    return torch.softmax(x, dim=axis)
def _gelu(x):
    return torch.nn.functional.gelu(x, approximate="tanh")
def _silu(x):
    return torch.nn.functional.silu(x)
def _sigmoid(x):
    return torch.sigmoid(x)
def _layernorm(x, axis=-1, eps=1e-5):
    m = x.mean(dim=axis, keepdim=True)
    v = x.var(dim=axis, keepdim=True, unbiased=False)
    return (x - m) / torch.sqrt(v + eps)
def _scatter_add(tgt, idx, src, axis=0):
    return tgt.clone().index_add_(axis, idx, src)
def _segment_sum(src, seg, n):
    out = torch.zeros((n,) + src.shape[1:], dtype=src.dtype)
    return out.index_add_(0, seg, src)
def _pad(x, pw):
    flat = tuple(v for pair in reversed(pw) for v in pair)
    return torch.nn.functional.pad(x, flat)

kernel_name = 'standalone__linear_kernel_rfa__prompt'

def setup_inputs():

    _w = (lambda a: (lambda t: t.to(torch.bfloat16) if t.is_floating_point() else t)(torch.as_tensor(a)))
    B, H, Sq, Sk, D, M = 1, 32, 2048, 2048, 192, 16
    return {
        "q": _w((lambda *s: torch.randn(*s, dtype=torch.bfloat16) * 0.1)(B, H, Sq, D)),
        "k": _w((lambda *s: torch.randn(*s, dtype=torch.bfloat16) * 1.6)(B, H, Sk, D)),
        "v": _w((lambda *s: torch.randn(*s, dtype=torch.bfloat16) * 1.6)(B, H, Sk, D)),
        "omega": _w((lambda *s: torch.randn(*s, dtype=torch.bfloat16) * 1.6)(M, D)),
    }

def reference(q, k, v, omega):
    d = q.shape[-1]
    m = omega.shape[0]
    scale = float(d) ** -0.25
    qs = q * scale
    ks = k * scale
    q_proj = torch.einsum("bhsd,md->bhsm", qs, omega)
    k_proj = torch.einsum("bhsd,md->bhsm", ks, omega)
    q_sq = 0.5 * torch.einsum("bhsd,bhsd->bhs", qs, qs)[..., None]
    k_sq = 0.5 * torch.einsum("bhsd,bhsd->bhs", ks, ks)[..., None]
    inv_sqrt_m = float(m) ** -0.5
    phi_q = torch.exp(q_proj - q_sq) * inv_sqrt_m + 1e-6
    phi_k = torch.exp(k_proj - k_sq) * inv_sqrt_m + 1e-6
    kv = torch.einsum("bhsm,bhsd->bhmd", phi_k, v)
    z  = torch.einsum("bhsm->bhm", phi_k)
    num = torch.einsum("bhqm,bhmd->bhqd", phi_q, kv)
    den = torch.einsum("bhqm,bhm->bhq", phi_q, z)[..., None] + 1e-6
    return num / den
```

```asm
; @launch grid=(256,1,1) block=(1024,1,1) lds=162176
.amdgcn_target "amdgcn-amd-amdhsa--gfx950"
.text
.globl standalone__linear_kernel_rfa__prompt_kernel
.p2align 8
.type standalone__linear_kernel_rfa__prompt_kernel,@function
standalone__linear_kernel_rfa__prompt_kernel:
  s_cmp_ge_u32 s2, 256
  s_cbranch_scc1 L_end
  s_load_dwordx2 s[28:29], s[0:1], 8
  s_load_dwordx2 s[8:9], s[0:1], 0
  s_load_dwordx2 s[16:17], s[0:1], 16
  s_load_dwordx2 s[20:21], s[0:1], 24
  s_load_dwordx2 s[24:25], s[0:1], 32
  s_load_dwordx2 s[32:33], s[0:1], 48
  v_lshrrev_b32 v11, 6, v0
  v_and_b32 v1, 63, v0
  v_readfirstlane_b32 s3, v11
  s_mov_b32 s30, 25165824
  s_mov_b32 s31, 0x00020000
  s_mov_b32 s22, 6144
  s_mov_b32 s23, 0x00020000
  s_mov_b32 s26, 25165824
  s_mov_b32 s27, 0x00020000
  s_mov_b32 s34, 268435456
  s_mov_b32 s35, 0x00020000
  s_and_b32 s37, s2, 7
  s_lshl_b32 s37, s37, 2
  s_bfe_u32 s38, s2, 0x20003
  s_add_u32 s37, s37, s38
  s_lshr_b32 s38, s2, 5
  s_lshl_b32 s36, s37, 3
  s_add_u32 s36, s36, s38
  s_mul_i32 s36, s36, 98304
  v_lshlrev_b32 v9, 4, v1
  v_lshrrev_b32 v11, 3, v1
  v_mul_u32_u24 v11, 43, v11
  v_lshrrev_b32 v2, 3, v11
  v_and_b32 v2, 0x60, v2
  v_xor_b32 v2, v2, v9
  v_add_u32 v3, 344, v11
  v_lshrrev_b32 v3, 3, v3
  v_and_b32 v3, 0x60, v3
  v_xor_b32 v3, v3, v9
  v_add_u32 v4, 688, v11
  v_lshrrev_b32 v4, 3, v4
  v_and_b32 v4, 0x60, v4
  v_xor_b32 v4, v4, v9
  v_mov_b32 v10, 161792
  s_lshl_b32 s49, s37, 17
  s_cmp_lg_u32 s3, 0
  s_cbranch_scc1 L_notld
  s_setprio 3
  v_lshlrev_b32 v14, 2, v1
  v_add_u32 v14, 161920, v14
  v_mov_b32 v15, -3
  s_mov_b32 s40, s36
  s_mov_b32 s41, 0
  s_waitcnt lgkmcnt(0)
  s_mov_b32 s43, 3
  s_call_b64 s[64:65], L_ld20
  s_waitcnt lgkmcnt(0)
  s_barrier
  s_mov_b32 s43, 1
  s_call_b64 s[64:65], L_ld20
  s_mov_b32 s43, 12
  s_call_b64 s[64:65], L_ld20
  s_mov_b64 s[28:29], s[16:17]
  s_mov_b32 s40, s36
  s_mov_b32 s43, 8
  s_call_b64 s[64:65], L_ld20
L_w1:
  ds_read_b32 v11, v10 offset:4
  s_waitcnt lgkmcnt(0)
  v_readfirstlane_b32 s47, v11
  s_nop 0
  s_and_b32 s47, s47, 15
  s_cmp_eq_u32 s47, 4
  s_cbranch_scc1 L_w1_d
  s_branch L_w1
L_w1_d:
  s_mov_b32 s41, 0
  s_mov_b32 s43, 8
  s_call_b64 s[64:65], L_ld20
L_w2:
  ds_read_b32 v11, v10 offset:4
  s_waitcnt lgkmcnt(0)
  v_readfirstlane_b32 s47, v11
  s_nop 0
  s_cmp_eq_u32 s47, 68
  s_cbranch_scc1 L_w2_d
  s_branch L_w2
L_w2_d:
  s_mov_b64 s[28:29], s[8:9]
  s_mov_b32 s40, s36
  s_mov_b32 s43, 8
  s_call_b64 s[64:65], L_ld20
L_w3:
  ds_read_b32 v11, v10 offset:16
  s_waitcnt lgkmcnt(0)
  v_readfirstlane_b32 s47, v11
  s_nop 0
  s_cmp_eq_u32 s47, 4
  s_cbranch_scc1 L_w3_d
  s_branch L_w3
L_w3_d:
  v_mov_b32 v15, 36
  s_mov_b32 s43, 8
  s_call_b64 s[64:65], L_ld30
  s_waitcnt vmcnt(24)
  ds_write_b32 v14, v15
  v_add_u32 v15, 1, v15
  s_waitcnt vmcnt(18)
  ds_write_b32 v14, v15
  v_add_u32 v15, 1, v15
  s_waitcnt vmcnt(12)
  ds_write_b32 v14, v15
  v_add_u32 v15, 1, v15
  s_waitcnt vmcnt(6)
  ds_write_b32 v14, v15
  v_add_u32 v15, 1, v15
  s_waitcnt vmcnt(0)
  ds_write_b32 v14, v15
  s_branch L_fin
L_ld20:
  s_mov_b32 m0, s41
  s_add_u32 s42, s40, 4096
  s_waitcnt vmcnt(19)
  buffer_load_dwordx4 v2, s[28:31], s40 offen offset:0 nt lds
  s_waitcnt vmcnt(19)
  buffer_load_dwordx4 v3, s[28:31], s40 offen offset:1024 nt lds
  ds_write_b32 v14, v15
  v_add_u32 v15, 1, v15
  s_waitcnt vmcnt(19)
  buffer_load_dwordx4 v4, s[28:31], s40 offen offset:2048 nt lds
  s_waitcnt vmcnt(19)
  buffer_load_dwordx4 v2, s[28:31], s40 offen offset:3072 nt lds
  s_add_u32 m0, s41, 4096
  s_waitcnt vmcnt(19)
  buffer_load_dwordx4 v3, s[28:31], s42 offen offset:0 nt lds
  s_waitcnt vmcnt(19)
  buffer_load_dwordx4 v4, s[28:31], s42 offen offset:1024 nt lds
  s_add_u32 s40, s40, 6144
  s_add_u32 s41, s41, 6144
  s_sub_u32 s43, s43, 1
  s_cmp_lg_u32 s43, 0
  s_cbranch_scc1 L_ld20
  s_setpc_b64 s[64:65]
L_ld30:
  s_mov_b32 m0, s41
  s_add_u32 s42, s40, 4096
  s_waitcnt vmcnt(29)
  buffer_load_dwordx4 v2, s[28:31], s40 offen offset:0 nt lds
  s_waitcnt vmcnt(29)
  buffer_load_dwordx4 v3, s[28:31], s40 offen offset:1024 nt lds
  s_waitcnt vmcnt(29)
  buffer_load_dwordx4 v4, s[28:31], s40 offen offset:2048 nt lds
  s_waitcnt vmcnt(29)
  buffer_load_dwordx4 v2, s[28:31], s40 offen offset:3072 nt lds
  s_add_u32 m0, s41, 4096
  s_waitcnt vmcnt(29)
  buffer_load_dwordx4 v3, s[28:31], s42 offen offset:0 nt lds
  s_waitcnt vmcnt(29)
  buffer_load_dwordx4 v4, s[28:31], s42 offen offset:1024 nt lds
  ds_write_b32 v14, v15
  v_add_u32 v15, 1, v15
  s_add_u32 s40, s40, 6144
  s_add_u32 s41, s41, 6144
  s_sub_u32 s43, s43, 1
  s_cmp_lg_u32 s43, 0
  s_cbranch_scc1 L_ld30
  s_setpc_b64 s[64:65]
L_notld:
  s_cmp_ge_u32 s3, 8
  s_cbranch_scc1 L_pwave
  s_cmp_lg_u32 s3, 1
  s_cbranch_scc1 L_x_bar
  v_lshlrev_b32 v16, 2, v1
  v_and_b32 v16, 60, v16
  v_add_u32 v16, 161792, v16
  v_mov_b32 v17, 0
  ds_write_b32 v16, v17
  s_mov_b32 m0, 155648
  s_movk_i32 s42, 0x1000
  s_waitcnt lgkmcnt(0)
  buffer_load_dwordx4 v2, s[20:23], 0 offen offset:0  lds
  buffer_load_dwordx4 v3, s[20:23], 0 offen offset:1024  lds
  buffer_load_dwordx4 v4, s[20:23], 0 offen offset:2048  lds
  buffer_load_dwordx4 v2, s[20:23], 0 offen offset:3072  lds
  s_mov_b32 m0, 159744
  s_nop 0
  buffer_load_dwordx4 v3, s[20:23], s42 offen offset:0  lds
  buffer_load_dwordx4 v4, s[20:23], s42 offen offset:1024  lds
L_x_bar:
  s_waitcnt lgkmcnt(0)
  s_add_u32 s75, s49, 107520
  s_load_dword s74, s[32:33], s75
  s_barrier
  s_cmp_lg_u32 s3, 1
  s_cbranch_scc1 L_x_noom
  s_waitcnt vmcnt(0)
  s_mov_b64 exec, 1
  v_mov_b32 v11, 1
  ds_add_u32 v10, v11 offset:0
  s_mov_b64 exec, -1
L_x_noom:
  v_mov_b32 v13, 1.0
  s_waitcnt lgkmcnt(0)
  s_add_u32 s74, s74, 1
  s_and_b32 s76, s74, 31
  s_cmp_lg_u32 s3, 3
  s_cbranch_scc1 L_x_noid
  s_getreg_b32 s42, hwreg(HW_REG_XCC_ID, 0, 4)
  s_lshl_b32 s77, s74, 4
  s_or_b32 s77, s77, s42
  s_add_u32 s43, s49, 107648
  s_lshl_b32 s42, s38, 2
  s_add_u32 s42, s42, s43
  v_mov_b32 v11, s77
  s_mov_b64 exec, 1
  buffer_store_dword v11, off, s[32:35], s42 sc1
  s_mov_b64 exec, -1
L_x_noid:
  v_lshrrev_b32 v11, 4, v1
  v_mul_u32_u24 v15, 1536, v11
  v_lshlrev_b32 v17, 3, v11
  v_add_u32 v17, 161856, v17
  v_and_b32 v11, 15, v1
  v_lshl_add_u32 v16, v11, 3, v15
  v_add_u32 v16, 256, v16
  v_lshl_add_u32 v15, v11, 4, v15
  v_add_u32 v2, 147456, v9
  s_mul_i32 s79, s37, 786432
  s_cmp_lt_u32 s3, 4
  s_cbranch_scc1 L_rwave
  s_and_b32 s39, s3, 3
  v_lshrrev_b32 v11, 2, v1
  v_mul_u32_u24 v14, 384, v11
  v_bfe_u32 v11, v1, 3, 2
  v_xor_b32 v11, s39, v11
  v_lshl_add_u32 v14, v11, 5, v14
  v_and_b32 v11, 3, v1
  v_lshl_add_u32 v14, v11, 3, v14
  v_add_u32 v14, 98304, v14
  v_lshrrev_b32 v11, 5, v1
  v_mul_u32_u24 v11, 3584, v11
  v_add_u32 v8, v11, v9
  s_lshl_b32 s54, s39, 13
  s_lshl_b32 s42, s38, 9
  s_add_u32 s54, s54, s42
  s_add_u32 s54, s54, s79
  s_add_u32 s55, s54, 32768
  s_add_u32 s56, s54, 65536
  s_mul_i32 s42, s39, 6
  s_add_u32 s42, s42, 0
  v_lshrrev_b32 v20, 4, v1
  v_add_u32 v20, s42, v20
  v_lshrrev_b32 v21, 1, v20
  v_and_b32 v22, 1, v20
  v_bfe_u32 v23, v1, 3, 1
  v_lshl_add_u32 v22, v22, 1, v23
  v_and_b32 v23, 7, v1
  v_and_b32 v24, 3, v23
  v_lshlrev_b32 v24, 10, v24
  v_lshrrev_b32 v25, 2, v23
  v_lshl_add_u32 v25, v21, 1, v25
  v_lshl_add_u32 v24, v25, 4, v24
  v_and_b32 v26, 1, v23
  v_lshlrev_b32 v26, 10, v26
  v_lshrrev_b32 v27, 1, v23
  v_lshl_add_u32 v27, v21, 2, v27
  v_lshl_add_u32 v26, v27, 4, v26
  v_add_u32 v26, 3584, v26
  v_cmp_gt_u32 vcc, 8, v21
  s_nop 1
  v_cndmask_b32 v24, v26, v24, vcc
  v_lshl_add_u32 v5, v22, 8, v24
  s_mul_i32 s42, s39, 6
  s_add_u32 s42, s42, 3
  v_lshrrev_b32 v20, 4, v1
  v_add_u32 v20, s42, v20
  v_lshrrev_b32 v21, 1, v20
  v_and_b32 v22, 1, v20
  v_bfe_u32 v23, v1, 3, 1
  v_lshl_add_u32 v22, v22, 1, v23
  v_and_b32 v23, 7, v1
  v_and_b32 v24, 3, v23
  v_lshlrev_b32 v24, 10, v24
  v_lshrrev_b32 v25, 2, v23
  v_lshl_add_u32 v25, v21, 1, v25
  v_lshl_add_u32 v24, v25, 4, v24
  v_and_b32 v26, 1, v23
  v_lshlrev_b32 v26, 10, v26
  v_lshrrev_b32 v27, 1, v23
  v_lshl_add_u32 v27, v21, 2, v27
  v_lshl_add_u32 v26, v27, 4, v26
  v_add_u32 v26, 3584, v26
  v_cmp_gt_u32 vcc, 8, v21
  s_nop 1
  v_cndmask_b32 v24, v26, v24, vcc
  v_lshl_add_u32 v6, v22, 8, v24
  s_lshl_b32 s50, s39, 11
  s_add_u32 s50, s50, s49
  s_add_u32 s50, s50, 98304
  s_mov_b32 s52, -1
  s_mov_b32 s53, 0xffff
  s_mov_b64 exec, 0
  s_branch L_t_post
L_t_dry_ret:
  s_mov_b64 exec, -1
  s_nop 7
L_w5:
  ds_read_b32 v11, v10 offset:20
  s_waitcnt lgkmcnt(0)
  v_readfirstlane_b32 s47, v11
  s_nop 0
  s_cmp_lg_u32 s47, 0
  s_cbranch_scc1 L_w5_d
  s_sleep 4
  s_branch L_w5
L_w5_d:
  s_sub_u32 s78, s47, 1
  s_mov_b32 s42, -1
  v_mov_b32 v20, s42
  v_mov_b32 v21, s42
  v_mov_b32 v22, s42
  v_mov_b32 v23, s42
  s_cmp_eq_u32 s78, 0
  s_cbranch_scc1 L_xs6_s
  buffer_store_dwordx4 v[20:23], v8, s[24:27], s54 offen
  buffer_store_dwordx4 v[20:23], v8, s[24:27], s55 offen
  buffer_store_dwordx4 v[20:23], v8, s[24:27], s56 offen
L_xs6_w:
  s_waitcnt vmcnt(0)
  s_mov_b64 exec, 1
  v_mov_b32 v11, 1
  ds_add_u32 v10, v11 offset:24
  s_mov_b64 exec, -1
  v_mov_b32 v36, 0
  v_mov_b32 v37, 0
  v_mov_b32 v38, 0
  v_mov_b32 v39, 0
  v_mov_b32 v40, 0
  v_mov_b32 v41, 0
  v_mov_b32 v42, 0
  v_mov_b32 v43, 0
  v_mov_b32 v44, 0
  v_mov_b32 v45, 0
  v_mov_b32 v46, 0
  v_mov_b32 v47, 0
  s_mov_b32 s43, 18
  s_mov_b32 s57, -135168
  s_setprio 2
L_w8:
  ds_read_b32 v11, v10 offset:4
  s_waitcnt lgkmcnt(0)
  v_readfirstlane_b32 s47, v11
  s_nop 0
  s_cmp_eq_u32 s47, 68
  s_cbranch_scc1 L_w8_d
  s_sleep 1
  s_branch L_w8
L_w8_d:
L_t_loop:
  ds_read_b128 v[20:23], v2
L_w9:
  ds_read_b32 v11, v10 offset:128
  s_waitcnt lgkmcnt(0)
  v_readfirstlane_b32 s47, v11
  s_nop 0
  s_cmp_ge_i32 s47, s43
  s_cbranch_scc1 L_w9_d
  s_sleep 1
  s_branch L_w9
L_w9_d:
  ds_read_b64_tr_b16 v[24:25], v14 offset:0
  ds_read_b64_tr_b16 v[26:27], v14 offset:6144
  ds_read_b64_tr_b16 v[28:29], v14 offset:128
  ds_read_b64_tr_b16 v[30:31], v14 offset:6272
  ds_read_b64_tr_b16 v[32:33], v14 offset:256
  ds_read_b64_tr_b16 v[34:35], v14 offset:6400
  s_cmp_eq_u32 s43, 24
  s_cselect_b32 s42, s57, 0x3000
  v_add_u32 v14, s42, v14
  v_add_u32 v2, 0x400, v2
  s_waitcnt lgkmcnt(4)
  v_mfma_f32_16x16x32_bf16 v[36:39], v[20:23], v[24:27], v[36:39]
  s_waitcnt lgkmcnt(2)
  v_mfma_f32_16x16x32_bf16 v[40:43], v[20:23], v[28:31], v[40:43]
  s_waitcnt lgkmcnt(0)
  v_mfma_f32_16x16x32_bf16 v[44:47], v[20:23], v[32:35], v[44:47]
  s_cbranch_scc0 L_t_nosig
  s_mov_b64 exec, 1
  v_mov_b32 v11, 1
  ds_add_u32 v10, v11 offset:16
  s_mov_b64 exec, -1
L_t_nosig:
  s_add_u32 s43, s43, 2
  s_cmp_le_u32 s43, 32
  s_cbranch_scc1 L_t_loop
L_t_post:
  v_min_u32 v36, -2, v36
  v_min_u32 v37, -2, v37
  v_min_u32 v38, -2, v38
  v_min_u32 v39, -2, v39
  v_min_u32 v40, -2, v40
  v_min_u32 v41, -2, v41
  v_min_u32 v42, -2, v42
  v_min_u32 v43, -2, v43
  v_min_u32 v44, -2, v44
  v_min_u32 v45, -2, v45
  v_min_u32 v46, -2, v46
  v_min_u32 v47, -2, v47
  s_cbranch_execz L_t_nops
  s_cmp_eq_u32 s78, 0
  s_cbranch_scc1 L_xs11_s
  buffer_store_dwordx4 v[36:39], v8, s[24:27], s54 offen
  buffer_store_dwordx4 v[40:43], v8, s[24:27], s55 offen
  buffer_store_dwordx4 v[44:47], v8, s[24:27], s56 offen
L_xs11_w:
L_t_nops:
  s_cbranch_execz L_sg12
  s_mov_b64 exec, 1
  v_mov_b32 v11, 1
  ds_add_u32 v10, v11 offset:8
  s_mov_b64 exec, -1
L_sg12:
  s_cbranch_execz L_c2_d
L_c2:
  ds_read_b32 v11, v10 offset:8
  s_waitcnt lgkmcnt(0)
  v_readfirstlane_b32 s47, v11
  s_nop 0
  s_and_b32 s48, s47, 31
  s_cmp_eq_u32 s48, 20
  s_cselect_b32 s47, s47, 0
  s_cmp_ge_u32 s47, 32
  s_cbranch_scc1 L_c2_d
  s_sleep 1
  s_branch L_c2
L_c2_d:
  s_and_b64 s[72:73], exec, s[52:53]
  s_cbranch_execz L_pp13_c
  s_mov_b64 s[80:81], s[72:73]
  s_mov_b64 s[82:83], s[72:73]
  s_mov_b32 s48, 0
L_pp13:
  s_cmp_ge_u32 s48, s78
  s_cbranch_scc1 L_pp13_sb
  s_mov_b64 exec, s[80:81]
  buffer_load_dwordx4 v[104:107], v9, s[32:35], s50 offen offset:0 nt
  s_mov_b64 exec, s[82:83]
  buffer_load_dwordx4 v[108:111], v9, s[32:35], s50 offen offset:1024 nt
L_pp13_wb:
  s_waitcnt vmcnt(0)
L_pp13_c:
  s_mov_b64 exec, s[72:73]
  v_max3_u32 v120, v104, v105, v106
  v_max3_u32 v121, v108, v109, v110
  v_max_u32 v120, v120, v107
  v_max_u32 v121, v121, v111
  v_cmp_eq_u32 s[80:81], -1, v120
  v_cmp_eq_u32 s[82:83], -1, v121
  s_nop 0
  s_or_b64 vcc, s[80:81], s[82:83]
  s_cbranch_scc0 L_pp13_d
  s_add_u32 s48, s48, 1
  s_cmp_lt_u32 s48, 0x100000
  s_cbranch_scc1 L_pp13
L_pp13_d:
  ds_write_b128 v5, v[104:107]
  ds_write_b128 v6, v[108:111]
  s_cbranch_execz L_sg14
  s_mov_b64 exec, 1
  v_mov_b32 v11, 1
  ds_add_u32 v10, v11 offset:12
  s_mov_b64 exec, -1
L_sg14:
  s_cbranch_execz L_t_dry_ret
  s_branch L_xout
L_rwave:
  v_lshlrev_b32 v5, 3, v1
  s_mul_i32 s50, s38, 3
  s_add_u32 s50, s50, s3
  s_sub_u32 s50, s50, 1
  s_lshl_b32 s50, s50, 12
  s_add_u32 s50, s50, s79
  s_lshl_b32 s51, s38, 2
  s_add_u32 s51, s51, s3
  s_sub_u32 s51, s51, 1
  s_lshl_b32 s51, s51, 8
  s_add_u32 s51, s51, s49
  s_add_u32 s51, s51, 98304
  s_cmp_lg_u32 s3, 1
  s_cbranch_scc1 L_r_noz
  v_lshrrev_b32 v11, 4, v1
  v_lshlrev_b32 v6, 3, v11
  v_add_u32 v6, 161856, v6
  v_and_b32 v7, 15, v1
  v_lshlrev_b32 v7, 2, v7
  v_lshl_add_u32 v7, v11, 7, v7
  v_and_b32 v14, 1, v1
  v_mul_u32_u24 v14, 63, v14
  v_add_u32 v14, v14, v1
  s_add_u32 s54, s49, 106496
  s_lshl_b32 s55, s38, 7
  s_add_u32 s55, s55, s54
  v_mov_b32 v124, 0x3f803f80
  v_mov_b32 v125, 0x3f803f80
  v_mov_b32 v126, 0x3f803f80
  v_mov_b32 v127, 0x3f803f80
  v_mov_b32 v20, -1
  v_mov_b32 v21, -1
  v_mov_b32 v22, -1
  v_mov_b32 v23, -1
  s_lshl_b32 s42, s38, 10
  s_add_u32 s42, s42, s49
  s_add_u32 s42, s42, 98304
L_w15:
  ds_read_b32 v11, v10 offset:20
  s_waitcnt lgkmcnt(0)
  v_readfirstlane_b32 s47, v11
  s_nop 0
  s_cmp_lg_u32 s47, 0
  s_cbranch_scc1 L_w15_d
  s_sleep 4
  s_branch L_w15
L_w15_d:
  s_sub_u32 s78, s47, 1
  s_cmp_eq_u32 s78, 0
  s_cbranch_scc1 L_xs16_s
  buffer_store_dwordx4 v[20:23], v9, s[32:35], s42 offen
L_xs16_w:
L_w17:
  ds_read_b32 v11, v10 offset:24
  s_waitcnt lgkmcnt(0)
  v_readfirstlane_b32 s47, v11
  s_nop 0
  s_cmp_eq_u32 s47, 4
  s_cbranch_scc1 L_w17_d
  s_sleep 4
  s_branch L_w17
L_w17_d:
L_w18:
  ds_read_b32 v11, v10 offset:4
  s_waitcnt lgkmcnt(0)
  v_readfirstlane_b32 s47, v11
  s_nop 0
  s_cmp_eq_u32 s47, 68
  s_cbranch_scc1 L_w18_d
  s_sleep 1
  s_branch L_w18
L_w18_d:
  s_waitcnt vmcnt(0)
  ds_read_b128 v[20:23], v2 offset:0
  ds_read_b128 v[24:27], v2 offset:1024
  ds_read_b128 v[28:31], v2 offset:2048
  ds_read_b128 v[32:35], v2 offset:3072
  ds_read_b128 v[36:39], v2 offset:4096
  ds_read_b128 v[40:43], v2 offset:5120
  ds_read_b128 v[44:47], v2 offset:6144
  ds_read_b128 v[48:51], v2 offset:7168
  s_waitcnt lgkmcnt(0)
  v_mfma_f32_16x16x32_bf16 v[56:59], v[20:23], v[124:127], 0
  v_mfma_f32_16x16x32_bf16 v[56:59], v[24:27], v[124:127], v[56:59]
  v_mfma_f32_16x16x32_bf16 v[56:59], v[28:31], v[124:127], v[56:59]
  v_mfma_f32_16x16x32_bf16 v[56:59], v[32:35], v[124:127], v[56:59]
  v_mfma_f32_16x16x32_bf16 v[56:59], v[36:39], v[124:127], v[56:59]
  v_mfma_f32_16x16x32_bf16 v[56:59], v[40:43], v[124:127], v[56:59]
  v_mfma_f32_16x16x32_bf16 v[56:59], v[44:47], v[124:127], v[56:59]
  v_mfma_f32_16x16x32_bf16 v[56:59], v[48:51], v[124:127], v[56:59]
  s_nop 7
  v_add_u32 v56, 16, v56
  v_bfi_b32 v56, 31, s76, v56
  v_add_u32 v57, 16, v57
  v_bfi_b32 v57, 31, s76, v57
  v_add_u32 v58, 16, v58
  v_bfi_b32 v58, 31, s76, v58
  v_add_u32 v59, 16, v59
  v_bfi_b32 v59, 31, s76, v59
  s_mov_b32 s52, 0x00030003
  s_mov_b32 s53, 0x00030003
  s_mov_b64 exec, s[52:53]
  s_cmp_eq_u32 s78, 0
  s_cbranch_scc1 L_xs19_s
  buffer_store_dwordx4 v[56:59], v14, s[32:35], s55 offen
L_xs19_w:
  s_mov_b64 exec, -1
  s_sleep 16
  s_cbranch_execz L_g20_c
  s_mov_b32 s48, 0
L_g20:
  s_cmp_ge_u32 s48, s78
  s_cbranch_scc1 L_g20_s
  buffer_load_dword v20, v7, s[32:35], s54 offen offset:0 nt
  buffer_load_dword v21, v7, s[32:35], s54 offen offset:512 nt
L_g20_w:
  s_waitcnt vmcnt(0)
L_g20_c:
  v_xor_b32 v20, s76, v20
  v_xor_b32 v21, s76, v21
  v_or_b32 v11, v20, v21
  v_and_b32 v11, 31, v11
  v_cmp_ne_u32 vcc, 0, v11
  s_nop 1
  s_cmp_eq_u64 vcc, 0
  s_cbranch_scc1 L_g20_d
  s_add_u32 s48, s48, 1
  s_cmp_lt_u32 s48, 0x100000
  s_cbranch_scc1 L_g20
L_g20_d:
  v_mfma_f32_16x16x4_f32 v[56:59], v20, v13, 0
  v_mfma_f32_16x16x4_f32 v[56:59], v21, v13, v[56:59]
  s_nop 9
  v_cvt_pk_bf16_f32 v60, v56, v57
  v_cvt_pk_bf16_f32 v61, v58, v59
  ds_write_b64 v6, v[60:61]
  s_mov_b64 exec, 1
  v_mov_b32 v11, 16
  ds_add_u32 v10, v11 offset:8
  s_mov_b64 exec, -1
  s_branch L_r_go
L_r_noz:
  s_mov_b64 exec, 0
  s_cmp_lg_u32 s3, 2
  s_cbranch_scc1 L_r_poll
  s_call_b64 s[64:65], L_out
L_r_dry_ret:
  s_mov_b64 exec, -1
  s_cmp_lg_u32 s3, 3
  s_cbranch_scc1 L_r_fl
L_w22:
  ds_read_b32 v11, v10 offset:128
  s_waitcnt lgkmcnt(0)
  v_readfirstlane_b32 s47, v11
  s_nop 0
  s_cmp_ge_i32 s47, 5
  s_cbranch_scc1 L_w22_d
  s_sleep 4
  s_branch L_w22
L_w22_d:
  v_lshlrev_b32 v7, 2, v1
  s_mov_b64 exec, 0xff
  s_mov_b32 s48, 0x100000
L_id:
  buffer_load_dword v20, v7, s[32:35], s43 offen sc1
  s_waitcnt vmcnt(0)
  v_xor_b32 v20, s77, v20
  v_cmp_lt_u32 vcc, 15, v20
  s_nop 1
  s_cmp_eq_u64 vcc, 0
  s_cbranch_scc1 L_id_d
  s_sleep 8
  s_sub_u32 s48, s48, 1
  s_cbranch_scc0 L_id
L_id_d:
  v_cmp_ne_u32 vcc, 0, v20
  s_nop 1
  s_cmp_eq_u64 vcc, 0
  s_cselect_b32 s42, 65, 1
  s_mov_b64 exec, 1
  v_mov_b32 v11, s42
  ds_add_u32 v10, v11 offset:20
  s_mov_b64 exec, -1
L_r_fl:
L_w24:
  ds_read_b32 v11, v10 offset:20
  s_waitcnt lgkmcnt(0)
  v_readfirstlane_b32 s47, v11
  s_nop 0
  s_cmp_lg_u32 s47, 0
  s_cbranch_scc1 L_w24_d
  s_sleep 4
  s_branch L_w24
L_w24_d:
  s_sub_u32 s78, s47, 1
L_r_go:
  s_setprio 2
L_w25:
  ds_read_b32 v11, v10 offset:8
  s_waitcnt lgkmcnt(0)
  v_readfirstlane_b32 s47, v11
  s_nop 0
  s_and_b32 s47, s47, 31
  s_cmp_eq_u32 s47, 20
  s_cbranch_scc1 L_w25_d
  s_sleep 1
  s_branch L_w25
L_w25_d:
L_r_poll:
  s_and_b64 s[72:73], exec, -1
  s_cbranch_execz L_pp26_c
  s_mov_b64 s[80:81], s[72:73]
  s_mov_b64 s[82:83], s[72:73]
  s_mov_b64 s[84:85], s[72:73]
  s_mov_b64 s[86:87], s[72:73]
  s_mov_b32 s48, 0
  s_cmp_ge_u32 s48, s78
  s_cbranch_scc1 L_pp26_sa
  s_mov_b64 exec, s[80:81]
  buffer_load_dwordx4 v[104:107], v9, s[24:27], s50 offen offset:0 nt
  s_mov_b64 exec, s[82:83]
  buffer_load_dwordx4 v[108:111], v9, s[24:27], s50 offen offset:1024 nt
  s_mov_b64 exec, s[84:85]
  buffer_load_dwordx4 v[112:115], v9, s[24:27], s50 offen offset:2048 nt
  s_mov_b64 exec, s[86:87]
  buffer_load_dwordx4 v[116:119], v9, s[24:27], s50 offen offset:3072 nt
L_pp26_wa:
  s_sleep 14
L_pp26:
  s_cmp_ge_u32 s48, s78
  s_cbranch_scc1 L_pp26_sb
  s_mov_b64 exec, s[80:81]
  buffer_load_dwordx4 v[104:107], v9, s[24:27], s50 offen offset:0 nt
  s_mov_b64 exec, s[82:83]
  buffer_load_dwordx4 v[108:111], v9, s[24:27], s50 offen offset:1024 nt
  s_mov_b64 exec, s[84:85]
  buffer_load_dwordx4 v[112:115], v9, s[24:27], s50 offen offset:2048 nt
  s_mov_b64 exec, s[86:87]
  buffer_load_dwordx4 v[116:119], v9, s[24:27], s50 offen offset:3072 nt
L_pp26_wb:
  s_waitcnt vmcnt(4)
L_pp26_c:
  s_mov_b64 exec, s[72:73]
  v_max3_u32 v120, v104, v105, v106
  v_max3_u32 v121, v108, v109, v110
  v_max3_u32 v122, v112, v113, v114
  v_max3_u32 v123, v116, v117, v118
  v_max_u32 v120, v120, v107
  v_max_u32 v121, v121, v111
  v_max_u32 v122, v122, v115
  v_max_u32 v123, v123, v119
  v_cmp_eq_u32 s[80:81], -1, v120
  v_cmp_eq_u32 s[82:83], -1, v121
  v_cmp_eq_u32 s[84:85], -1, v122
  v_cmp_eq_u32 s[86:87], -1, v123
  s_nop 0
  s_or_b64 vcc, s[80:81], s[82:83]
  s_or_b64 vcc, vcc, s[84:85]
  s_or_b64 vcc, vcc, s[86:87]
  s_cbranch_scc0 L_pp26_d
  s_add_u32 s48, s48, 1
  s_cmp_lt_u32 s48, 0x100000
  s_cbranch_scc1 L_pp26
L_pp26_d:
  v_pk_add_f32 v[20:21], v[104:105], v[108:109]
  v_pk_add_f32 v[22:23], v[106:107], v[110:111]
  v_pk_add_f32 v[20:21], v[20:21], v[112:113]
  v_pk_add_f32 v[22:23], v[22:23], v[114:115]
  v_pk_add_f32 v[20:21], v[20:21], v[116:117]
  v_pk_add_f32 v[22:23], v[22:23], v[118:119]
  s_nop 1
  v_permlane32_swap_b32 v20, v22
  v_permlane32_swap_b32 v21, v23
  v_pk_add_f32 v[20:21], v[20:21], v[22:23]
  v_cvt_pk_bf16_f32 v24, v20, v21
  v_min_u32 v24, -2, v24
  v_mov_b32 v25, v24
  s_nop 1
  v_permlane32_swap_b32 v24, v25
  s_cbranch_execz L_r_dry_ret
  s_mov_b32 s52, -1
  s_mov_b32 s53, 0
  s_mov_b64 exec, s[52:53]
  s_cmp_eq_u32 s78, 0
  s_cbranch_scc1 L_xs27_s
  buffer_store_dwordx2 v[24:25], v5, s[32:35], s51 offen
L_xs27_w:
  s_mov_b64 exec, 1
  v_mov_b32 v11, 32
  ds_add_u32 v10, v11 offset:8
  s_mov_b64 exec, -1
  s_lshl_b32 s42, s38, 4
  s_add_u32 s42, s42, s3
  s_cmp_lg_u32 s42, 1
  s_cbranch_scc1 L_xout
L_w29:
  ds_read_b32 v11, v10 offset:12
  s_waitcnt lgkmcnt(0)
  v_readfirstlane_b32 s47, v11
  s_nop 0
  s_and_b32 s47, s47, 7
  s_cmp_eq_u32 s47, 4
  s_cbranch_scc1 L_w29_d
  s_sleep 1
  s_branch L_w29
L_w29_d:
  v_mov_b32 v11, s74
  s_mov_b64 exec, 1
  buffer_store_dword v11, off, s[32:35], s75 sc1
  s_mov_b64 exec, -1
L_xout:
  s_setprio 0
  s_mul_i32 s40, s3, 6144
  s_add_u32 s52, s40, s36
  s_add_u32 s40, s40, 49152
  v_lshlrev_b32 v14, 3, v1
  v_add_u32 v14, s40, v14
  s_lshl_b32 s42, 0x100, s3
  s_or_b32 s43, s42, 4
  s_or_b32 s42, s42, 7
L_w30:
  ds_read_b32 v11, v10 offset:12
  s_waitcnt lgkmcnt(0)
  v_readfirstlane_b32 s47, v11
  s_nop 0
  s_and_b32 s47, s47, s42
  s_cmp_eq_u32 s47, s43
  s_cbranch_scc1 L_w30_d
  s_sleep 1
  s_branch L_w30
L_w30_d:
  ds_read_b64 v[30:31], v14
  s_mov_b32 s53, 0
  s_branch L_out
L_phi:
  v_add_u32 v5, s41, v7
  v_add_u32 v6, s41, v8
  v_mov_b32 v40, 0
  v_mov_b32 v41, 0
L_w31:
  ds_read_b32 v11, v10 offset:128
  s_waitcnt lgkmcnt(0)
  v_readfirstlane_b32 s47, v11
  s_nop 0
  s_cmp_ge_i32 s47, s43
  s_cbranch_scc1 L_w31_d
  s_sleep 1
  s_branch L_w31
L_w31_d:
  ds_read_b128 v[64:67], v5 offset:0
  ds_read_b128 v[68:71], v6 offset:0
  ds_read_b128 v[72:75], v5 offset:128
  ds_read_b128 v[76:79], v6 offset:128
  ds_read_b128 v[80:83], v5 offset:256
  ds_read_b128 v[84:87], v6 offset:256
  s_waitcnt lgkmcnt(5)
  v_lshlrev_b32 v32, 16, v64
  v_and_b32 v33, s46, v64
  v_lshlrev_b32 v34, 16, v65
  v_and_b32 v35, s46, v65
  v_lshlrev_b32 v36, 16, v66
  v_and_b32 v37, s46, v66
  v_lshlrev_b32 v38, 16, v67
  v_and_b32 v39, s46, v67
  v_pk_mul_f32 v[32:33], v[32:33], s[44:45]
  v_pk_mul_f32 v[34:35], v[34:35], s[44:45]
  v_pk_mul_f32 v[36:37], v[36:37], s[44:45]
  v_pk_mul_f32 v[38:39], v[38:39], s[44:45]
  v_cvt_pk_bf16_f32 v64, v32, v33
  v_cvt_pk_bf16_f32 v65, v34, v35
  v_cvt_pk_bf16_f32 v66, v36, v37
  v_cvt_pk_bf16_f32 v67, v38, v39
  v_dot2c_f32_bf16 v40, v64, v64
  v_dot2c_f32_bf16 v41, v65, v65
  v_dot2c_f32_bf16 v40, v66, v66
  v_dot2c_f32_bf16 v41, v67, v67
  s_waitcnt lgkmcnt(4)
  v_lshlrev_b32 v32, 16, v68
  v_and_b32 v33, s46, v68
  v_lshlrev_b32 v34, 16, v69
  v_and_b32 v35, s46, v69
  v_lshlrev_b32 v36, 16, v70
  v_and_b32 v37, s46, v70
  v_lshlrev_b32 v38, 16, v71
  v_and_b32 v39, s46, v71
  v_pk_mul_f32 v[32:33], v[32:33], s[44:45]
  v_pk_mul_f32 v[34:35], v[34:35], s[44:45]
  v_pk_mul_f32 v[36:37], v[36:37], s[44:45]
  v_pk_mul_f32 v[38:39], v[38:39], s[44:45]
  v_cvt_pk_bf16_f32 v68, v32, v33
  v_cvt_pk_bf16_f32 v69, v34, v35
  v_cvt_pk_bf16_f32 v70, v36, v37
  v_cvt_pk_bf16_f32 v71, v38, v39
  v_dot2c_f32_bf16 v40, v68, v68
  v_dot2c_f32_bf16 v41, v69, v69
  v_dot2c_f32_bf16 v40, v70, v70
  v_dot2c_f32_bf16 v41, v71, v71
  s_waitcnt lgkmcnt(3)
  v_lshlrev_b32 v32, 16, v72
  v_and_b32 v33, s46, v72
  v_lshlrev_b32 v34, 16, v73
  v_and_b32 v35, s46, v73
  v_lshlrev_b32 v36, 16, v74
  v_and_b32 v37, s46, v74
  v_lshlrev_b32 v38, 16, v75
  v_and_b32 v39, s46, v75
  v_pk_mul_f32 v[32:33], v[32:33], s[44:45]
  v_pk_mul_f32 v[34:35], v[34:35], s[44:45]
  v_pk_mul_f32 v[36:37], v[36:37], s[44:45]
  v_pk_mul_f32 v[38:39], v[38:39], s[44:45]
  v_cvt_pk_bf16_f32 v72, v32, v33
  v_cvt_pk_bf16_f32 v73, v34, v35
  v_cvt_pk_bf16_f32 v74, v36, v37
  v_cvt_pk_bf16_f32 v75, v38, v39
  v_dot2c_f32_bf16 v40, v72, v72
  v_dot2c_f32_bf16 v41, v73, v73
  v_dot2c_f32_bf16 v40, v74, v74
  v_dot2c_f32_bf16 v41, v75, v75
  s_waitcnt lgkmcnt(2)
  v_lshlrev_b32 v32, 16, v76
  v_and_b32 v33, s46, v76
  v_lshlrev_b32 v34, 16, v77
  v_and_b32 v35, s46, v77
  v_lshlrev_b32 v36, 16, v78
  v_and_b32 v37, s46, v78
  v_lshlrev_b32 v38, 16, v79
  v_and_b32 v39, s46, v79
  v_pk_mul_f32 v[32:33], v[32:33], s[44:45]
  v_pk_mul_f32 v[34:35], v[34:35], s[44:45]
  v_pk_mul_f32 v[36:37], v[36:37], s[44:45]
  v_pk_mul_f32 v[38:39], v[38:39], s[44:45]
  v_cvt_pk_bf16_f32 v76, v32, v33
  v_cvt_pk_bf16_f32 v77, v34, v35
  v_cvt_pk_bf16_f32 v78, v36, v37
  v_cvt_pk_bf16_f32 v79, v38, v39
  v_dot2c_f32_bf16 v40, v76, v76
  v_dot2c_f32_bf16 v41, v77, v77
  v_dot2c_f32_bf16 v40, v78, v78
  v_dot2c_f32_bf16 v41, v79, v79
  s_waitcnt lgkmcnt(1)
  v_lshlrev_b32 v32, 16, v80
  v_and_b32 v33, s46, v80
  v_lshlrev_b32 v34, 16, v81
  v_and_b32 v35, s46, v81
  v_lshlrev_b32 v36, 16, v82
  v_and_b32 v37, s46, v82
  v_lshlrev_b32 v38, 16, v83
  v_and_b32 v39, s46, v83
  v_pk_mul_f32 v[32:33], v[32:33], s[44:45]
  v_pk_mul_f32 v[34:35], v[34:35], s[44:45]
  v_pk_mul_f32 v[36:37], v[36:37], s[44:45]
  v_pk_mul_f32 v[38:39], v[38:39], s[44:45]
  v_cvt_pk_bf16_f32 v80, v32, v33
  v_cvt_pk_bf16_f32 v81, v34, v35
  v_cvt_pk_bf16_f32 v82, v36, v37
  v_cvt_pk_bf16_f32 v83, v38, v39
  v_dot2c_f32_bf16 v40, v80, v80
  v_dot2c_f32_bf16 v41, v81, v81
  v_dot2c_f32_bf16 v40, v82, v82
  v_dot2c_f32_bf16 v41, v83, v83
  s_waitcnt lgkmcnt(0)
  v_lshlrev_b32 v32, 16, v84
  v_and_b32 v33, s46, v84
  v_lshlrev_b32 v34, 16, v85
  v_and_b32 v35, s46, v85
  v_lshlrev_b32 v36, 16, v86
  v_and_b32 v37, s46, v86
  v_lshlrev_b32 v38, 16, v87
  v_and_b32 v39, s46, v87
  v_pk_mul_f32 v[32:33], v[32:33], s[44:45]
  v_pk_mul_f32 v[34:35], v[34:35], s[44:45]
  v_pk_mul_f32 v[36:37], v[36:37], s[44:45]
  v_pk_mul_f32 v[38:39], v[38:39], s[44:45]
  v_cvt_pk_bf16_f32 v84, v32, v33
  v_cvt_pk_bf16_f32 v85, v34, v35
  v_cvt_pk_bf16_f32 v86, v36, v37
  v_cvt_pk_bf16_f32 v87, v38, v39
  v_dot2c_f32_bf16 v40, v84, v84
  v_dot2c_f32_bf16 v41, v85, v85
  v_dot2c_f32_bf16 v40, v86, v86
  v_dot2c_f32_bf16 v41, v87, v87
  s_cmp_ge_u32 s43, 32
  s_nop 1
  v_add_f32 v40, v40, v41
  s_cbranch_scc1 L_phi_q
  s_nop 0
  v_mfma_f32_16x16x4_f32 v[24:27], v40, v13, 0
  v_mfma_f32_16x16x32_bf16 v[20:23], v[64:67], v[104:107], 0
  v_mfma_f32_16x16x32_bf16 v[20:23], v[68:71], v[108:111], v[20:23]
  v_mfma_f32_16x16x32_bf16 v[20:23], v[72:75], v[112:115], v[20:23]
  v_mfma_f32_16x16x32_bf16 v[20:23], v[76:79], v[116:119], v[20:23]
  v_mfma_f32_16x16x32_bf16 v[20:23], v[80:83], v[120:123], v[20:23]
  v_mfma_f32_16x16x32_bf16 v[20:23], v[84:87], v[124:127], v[20:23]
  s_branch L_phi_j
L_phi_q:
  s_nop 0
  v_mfma_f32_16x16x4_f32 v[24:27], v13, v40, 0
  v_mfma_f32_16x16x32_bf16 v[20:23], v[104:107], v[64:67], 0
  v_mfma_f32_16x16x32_bf16 v[20:23], v[108:111], v[68:71], v[20:23]
  v_mfma_f32_16x16x32_bf16 v[20:23], v[112:115], v[72:75], v[20:23]
  v_mfma_f32_16x16x32_bf16 v[20:23], v[116:119], v[76:79], v[20:23]
  v_mfma_f32_16x16x32_bf16 v[20:23], v[120:123], v[80:83], v[20:23]
  v_mfma_f32_16x16x32_bf16 v[20:23], v[124:127], v[84:87], v[20:23]
L_phi_j:
  s_nop 3
  v_cvt_pk_bf16_f32 v24, 0, v24
  v_cvt_pk_bf16_f32 v25, 0, v25
  v_cvt_pk_bf16_f32 v26, 0, v26
  v_cvt_pk_bf16_f32 v27, 0, v27
  v_cvt_pk_bf16_f32 v20, 0, v20
  v_cvt_pk_bf16_f32 v21, 0, v21
  v_cvt_pk_bf16_f32 v22, 0, v22
  v_cvt_pk_bf16_f32 v23, 0, v23
  v_fma_f32 v32, v24, -0.5, v20
  v_fma_f32 v33, v25, -0.5, v21
  v_fma_f32 v34, v26, -0.5, v22
  v_fma_f32 v35, v27, -0.5, v23
  v_cvt_pk_bf16_f32 v32, 0, v32
  v_cvt_pk_bf16_f32 v33, 0, v33
  v_cvt_pk_bf16_f32 v34, 0, v34
  v_cvt_pk_bf16_f32 v35, 0, v35
  v_mul_f32 v32, 0x3fb8aa3b, v32
  v_mul_f32 v33, 0x3fb8aa3b, v33
  v_mul_f32 v34, 0x3fb8aa3b, v34
  v_mul_f32 v35, 0x3fb8aa3b, v35
  v_exp_f32 v32, v32
  v_exp_f32 v33, v33
  v_exp_f32 v34, v34
  v_exp_f32 v35, v35
  v_cvt_pk_bf16_f32 v32, 0, v32
  v_cvt_pk_bf16_f32 v33, 0, v33
  v_cvt_pk_bf16_f32 v34, 0, v34
  v_cvt_pk_bf16_f32 v35, 0, v35
  v_mul_f32 v32, 0x3e800000, v32
  v_mul_f32 v33, 0x3e800000, v33
  v_mul_f32 v34, 0x3e800000, v34
  v_mul_f32 v35, 0x3e800000, v35
  v_add_f32 v32, 0x358637bd, v32
  v_add_f32 v33, 0x358637bd, v33
  v_add_f32 v34, 0x358637bd, v34
  v_add_f32 v35, 0x358637bd, v35
  v_mov_b32 v28, v30
  v_mov_b32 v29, v31
  v_cvt_pk_bf16_f32 v30, v32, v33
  v_cvt_pk_bf16_f32 v31, v34, v35
  s_setpc_b64 s[64:65]
L_out:
  ds_read_b64 v[18:19], v17
  ds_read_b128 v[80:83], v9 offset:0
  ds_read_b128 v[84:87], v9 offset:1024
  ds_read_b128 v[88:91], v9 offset:2048
  ds_read_b128 v[92:95], v9 offset:3072
  ds_read_b128 v[96:99], v9 offset:4096
  ds_read_b128 v[100:103], v9 offset:5120
L_out2:
  s_waitcnt lgkmcnt(6)
  v_mfma_f32_16x16x16_bf16 v[20:23], v[30:31], v[18:19], 0
  s_waitcnt lgkmcnt(5)
  v_mfma_f32_16x16x16_bf16 v[32:35], v[30:31], v[80:81], 0
  v_mfma_f32_16x16x16_bf16 v[36:39], v[30:31], v[82:83], 0
  s_waitcnt lgkmcnt(4)
  v_mfma_f32_16x16x16_bf16 v[40:43], v[30:31], v[84:85], 0
  s_nop 2
  v_cvt_pk_bf16_f32 v20, 0, v20
  v_cvt_pk_bf16_f32 v21, 0, v21
  v_cvt_pk_bf16_f32 v22, 0, v22
  v_cvt_pk_bf16_f32 v23, 0, v23
  v_mfma_f32_16x16x16_bf16 v[44:47], v[30:31], v[86:87], 0
  v_add_f32 v20, 0x358637bd, v20
  v_add_f32 v21, 0x358637bd, v21
  v_add_f32 v22, 0x358637bd, v22
  v_add_f32 v23, 0x358637bd, v23
  s_waitcnt lgkmcnt(3)
  v_mfma_f32_16x16x16_bf16 v[48:51], v[30:31], v[88:89], 0
  v_cvt_pk_bf16_f32 v20, 0, v20
  v_cvt_pk_bf16_f32 v21, 0, v21
  v_cvt_pk_bf16_f32 v22, 0, v22
  v_cvt_pk_bf16_f32 v23, 0, v23
  v_mfma_f32_16x16x16_bf16 v[52:55], v[30:31], v[90:91], 0
  v_rcp_f32 v24, v20
  v_rcp_f32 v25, v21
  v_rcp_f32 v26, v22
  v_rcp_f32 v27, v23
  s_waitcnt lgkmcnt(2)
  v_mfma_f32_16x16x16_bf16 v[56:59], v[30:31], v[92:93], 0
  v_mfma_f32_16x16x16_bf16 v[60:63], v[30:31], v[94:95], 0
  s_waitcnt lgkmcnt(1)
  v_mfma_f32_16x16x16_bf16 v[64:67], v[30:31], v[96:97], 0
  v_mfma_f32_16x16x16_bf16 v[68:71], v[30:31], v[98:99], 0
  s_waitcnt lgkmcnt(0)
  v_mfma_f32_16x16x16_bf16 v[72:75], v[30:31], v[100:101], 0
  v_mfma_f32_16x16x16_bf16 v[76:79], v[30:31], v[102:103], 0
  v_pk_mul_f32 v[32:33], v[32:33], v[24:25]
  v_pk_mul_f32 v[34:35], v[34:35], v[26:27]
  v_pk_mul_f32 v[36:37], v[36:37], v[24:25]
  v_pk_mul_f32 v[38:39], v[38:39], v[26:27]
  v_pk_mul_f32 v[40:41], v[40:41], v[24:25]
  v_pk_mul_f32 v[42:43], v[42:43], v[26:27]
  v_pk_mul_f32 v[44:45], v[44:45], v[24:25]
  v_pk_mul_f32 v[46:47], v[46:47], v[26:27]
  v_pk_mul_f32 v[48:49], v[48:49], v[24:25]
  v_pk_mul_f32 v[50:51], v[50:51], v[26:27]
  v_pk_mul_f32 v[52:53], v[52:53], v[24:25]
  v_pk_mul_f32 v[54:55], v[54:55], v[26:27]
  v_pk_mul_f32 v[56:57], v[56:57], v[24:25]
  v_pk_mul_f32 v[58:59], v[58:59], v[26:27]
  v_pk_mul_f32 v[60:61], v[60:61], v[24:25]
  v_pk_mul_f32 v[62:63], v[62:63], v[26:27]
  v_cvt_pk_bf16_f32 v80, v32, v36
  v_cvt_pk_bf16_f32 v81, v40, v44
  v_cvt_pk_bf16_f32 v82, v48, v52
  v_cvt_pk_bf16_f32 v83, v56, v60
  v_cvt_pk_bf16_f32 v84, v33, v37
  v_cvt_pk_bf16_f32 v85, v41, v45
  v_cvt_pk_bf16_f32 v86, v49, v53
  v_cvt_pk_bf16_f32 v87, v57, v61
  v_cvt_pk_bf16_f32 v88, v34, v38
  v_cvt_pk_bf16_f32 v89, v42, v46
  v_cvt_pk_bf16_f32 v90, v50, v54
  v_cvt_pk_bf16_f32 v91, v58, v62
  v_cvt_pk_bf16_f32 v92, v35, v39
  v_cvt_pk_bf16_f32 v93, v43, v47
  v_cvt_pk_bf16_f32 v94, v51, v55
  v_cvt_pk_bf16_f32 v95, v59, v63
  v_pk_mul_f32 v[64:65], v[64:65], v[24:25]
  v_pk_mul_f32 v[66:67], v[66:67], v[26:27]
  v_pk_mul_f32 v[68:69], v[68:69], v[24:25]
  v_pk_mul_f32 v[70:71], v[70:71], v[26:27]
  v_pk_mul_f32 v[72:73], v[72:73], v[24:25]
  v_pk_mul_f32 v[74:75], v[74:75], v[26:27]
  v_pk_mul_f32 v[76:77], v[76:77], v[24:25]
  v_pk_mul_f32 v[78:79], v[78:79], v[26:27]
  v_cvt_pk_bf16_f32 v96, v64, v68
  v_cvt_pk_bf16_f32 v97, v72, v76
  v_cvt_pk_bf16_f32 v98, v65, v69
  v_cvt_pk_bf16_f32 v99, v73, v77
  v_cvt_pk_bf16_f32 v100, v66, v70
  v_cvt_pk_bf16_f32 v101, v74, v78
  v_cvt_pk_bf16_f32 v102, v67, v71
  v_cvt_pk_bf16_f32 v103, v75, v79
  s_cbranch_execz L_os2
L_w32:
  ds_read_b32 v11, v10 offset:128
  s_waitcnt lgkmcnt(0)
  v_readfirstlane_b32 s47, v11
  s_nop 0
  s_cmp_ge_i32 s47, 47
  s_cbranch_scc1 L_w32_d
  s_sleep 1
  s_branch L_w32
L_w32_d:
  buffer_store_dwordx4 v[80:83], v15, s[24:27], s52 offen offset:0 nt
  buffer_store_dwordx2 v[96:97], v16, s[24:27], s52 offen offset:0 nt
  buffer_store_dwordx4 v[84:87], v15, s[24:27], s52 offen offset:384 nt
  buffer_store_dwordx2 v[98:99], v16, s[24:27], s52 offen offset:384 nt
  buffer_store_dwordx4 v[88:91], v15, s[24:27], s52 offen offset:768 nt
  buffer_store_dwordx2 v[100:101], v16, s[24:27], s52 offen offset:768 nt
  buffer_store_dwordx4 v[92:95], v15, s[24:27], s52 offen offset:1152 nt
  buffer_store_dwordx2 v[102:103], v16, s[24:27], s52 offen offset:1152 nt
  s_cmp_eq_u32 s53, 0
  s_cbranch_scc1 L_fin
  v_mov_b32 v30, v28
  v_mov_b32 v31, v29
  s_sub_u32 s52, s53, 1
  s_mov_b32 s53, 0
  s_branch L_out
L_os2:
  s_nop 7
  s_setpc_b64 s[64:65]
L_pwave:
  s_barrier
  s_and_b32 s39, s3, 7
  s_mov_b32 s44, 0x3e898b82
  s_mov_b32 s45, 0x3e898b82
  s_mov_b32 s46, 0xffff0000
  v_and_b32 v11, 15, v1
  v_lshrrev_b32 v8, 4, v1
  v_and_b32 v7, 6, v1
  v_xor_b32 v7, v7, v8
  v_lshlrev_b32 v7, 4, v7
  v_mul_u32_u24 v11, 384, v11
  v_add_u32 v7, v7, v11
  v_xor_b32 v8, 64, v7
  v_add_u32 v5, 155648, v7
  v_add_u32 v6, 155648, v8
  v_mov_b32 v13, 1.0
  v_lshrrev_b32 v11, 4, v1
  v_mul_u32_u24 v15, 1536, v11
  v_lshlrev_b32 v17, 3, v11
  v_add_u32 v17, 161856, v17
  v_and_b32 v11, 15, v1
  v_lshl_add_u32 v16, v11, 3, v15
  v_add_u32 v16, 256, v16
  v_lshl_add_u32 v15, v11, 4, v15
  s_mul_i32 s40, s39, 6144
  s_add_u32 s53, s40, s36
  s_add_u32 s52, s53, 49152
  s_add_u32 s53, s53, 1
  s_cmp_ge_u32 s39, 4
  s_cselect_b32 s54, 16, 1
  s_lshl_b32 s42, s39, 10
  s_add_u32 s42, s42, 147456
  v_add_u32 v14, s42, v9
  s_waitcnt lgkmcnt(0)
L_w33:
  ds_read_b32 v11, v10 offset:0
  s_waitcnt lgkmcnt(0)
  v_readfirstlane_b32 s47, v11
  s_nop 0
  s_cmp_eq_u32 s47, 1
  s_cbranch_scc1 L_w33_d
  s_sleep 1
  s_branch L_w33
L_w33_d:
  ds_read_b128 v[104:107], v5 offset:0
  ds_read_b128 v[108:111], v6 offset:0
  ds_read_b128 v[112:115], v5 offset:128
  ds_read_b128 v[116:119], v6 offset:128
  ds_read_b128 v[120:123], v5 offset:256
  ds_read_b128 v[124:127], v6 offset:256
  s_lshl_b32 s41, s40, 1
  s_lshl_b32 s43, s39, 1
  s_add_u32 s43, s43, 1
  s_call_b64 s[64:65], L_phi
  s_add_u32 s41, s41, 6144
  s_add_u32 s43, s43, 1
  s_call_b64 s[64:65], L_phi
  ds_write_b128 v14, v[28:31]
  s_mov_b64 exec, 1
  v_mov_b32 v11, s54
  ds_add_u32 v10, v11 offset:4
  s_mov_b64 exec, -1
  s_add_u32 s41, s40, 49152
  s_add_u32 s43, s39, 33
  s_call_b64 s[64:65], L_phi
  s_cmp_eq_u32 s39, 0
  s_cbranch_scc1 L_p_keep
  v_lshlrev_b32 v14, 3, v1
  v_add_u32 v14, s41, v14
  ds_write_b64 v14, v[30:31]
  s_lshl_b32 s42, 0x100, s39
  s_mov_b32 s53, 0
  s_mov_b64 exec, 1
  v_mov_b32 v11, s42
  ds_add_u32 v10, v11 offset:12
  s_mov_b64 exec, -1
L_p_keep:
  s_setprio 2
  s_add_u32 s41, s40, 98304
  s_add_u32 s43, s39, 41
  s_call_b64 s[64:65], L_phi
L_w36:
  ds_read_b32 v11, v10 offset:12
  s_waitcnt lgkmcnt(0)
  v_readfirstlane_b32 s47, v11
  s_nop 0
  s_and_b32 s47, s47, 7
  s_cmp_eq_u32 s47, 4
  s_cbranch_scc1 L_w36_d
  s_sleep 1
  s_branch L_w36
L_w36_d:
  s_branch L_out
L_fin:
L_end:
  s_endpgm
L_xs6_s:
  buffer_store_dwordx4 v[20:23], v8, s[24:27], s54 offen sc1
  buffer_store_dwordx4 v[20:23], v8, s[24:27], s55 offen sc1
  buffer_store_dwordx4 v[20:23], v8, s[24:27], s56 offen sc1
  s_branch L_xs6_w
L_xs11_s:
  buffer_store_dwordx4 v[36:39], v8, s[24:27], s54 offen sc1
  buffer_store_dwordx4 v[40:43], v8, s[24:27], s55 offen sc1
  buffer_store_dwordx4 v[44:47], v8, s[24:27], s56 offen sc1
  s_branch L_xs11_w
L_pp13_sb:
  s_mov_b64 exec, s[80:81]
  buffer_load_dwordx4 v[104:107], v9, s[32:35], s50 offen offset:0 sc1
  s_mov_b64 exec, s[82:83]
  buffer_load_dwordx4 v[108:111], v9, s[32:35], s50 offen offset:1024 sc1
  s_branch L_pp13_wb
L_xs16_s:
  buffer_store_dwordx4 v[20:23], v9, s[32:35], s42 offen sc1
  s_branch L_xs16_w
L_xs19_s:
  buffer_store_dwordx4 v[56:59], v14, s[32:35], s55 offen sc1
  s_branch L_xs19_w
L_g20_s:
  buffer_load_dword v20, v7, s[32:35], s54 offen offset:0 sc1
  buffer_load_dword v21, v7, s[32:35], s54 offen offset:512 sc1
  s_branch L_g20_w
L_pp26_sa:
  s_mov_b64 exec, s[80:81]
  buffer_load_dwordx4 v[104:107], v9, s[24:27], s50 offen offset:0 sc1
  s_mov_b64 exec, s[82:83]
  buffer_load_dwordx4 v[108:111], v9, s[24:27], s50 offen offset:1024 sc1
  s_mov_b64 exec, s[84:85]
  buffer_load_dwordx4 v[112:115], v9, s[24:27], s50 offen offset:2048 sc1
  s_mov_b64 exec, s[86:87]
  buffer_load_dwordx4 v[116:119], v9, s[24:27], s50 offen offset:3072 sc1
  s_branch L_pp26_wa
L_pp26_sb:
  s_mov_b64 exec, s[80:81]
  buffer_load_dwordx4 v[104:107], v9, s[24:27], s50 offen offset:0 sc1
  s_mov_b64 exec, s[82:83]
  buffer_load_dwordx4 v[108:111], v9, s[24:27], s50 offen offset:1024 sc1
  s_mov_b64 exec, s[84:85]
  buffer_load_dwordx4 v[112:115], v9, s[24:27], s50 offen offset:2048 sc1
  s_mov_b64 exec, s[86:87]
  buffer_load_dwordx4 v[116:119], v9, s[24:27], s50 offen offset:3072 sc1
  s_branch L_pp26_wb
L_xs27_s:
  buffer_store_dwordx2 v[24:25], v5, s[32:35], s51 offen sc1
  s_branch L_xs27_w
.section .rodata,"a"
.p2align 6
.amdhsa_kernel standalone__linear_kernel_rfa__prompt_kernel
  .amdhsa_next_free_vgpr 128
  .amdhsa_next_free_sgpr 96
  .amdhsa_accum_offset 128
  .amdhsa_group_segment_fixed_size 0
  .amdhsa_kernarg_size 56
  .amdhsa_user_sgpr_count 2
  .amdhsa_user_sgpr_kernarg_segment_ptr 1
  .amdhsa_system_sgpr_workgroup_id_x 1
  .amdhsa_float_denorm_mode_32 3
.end_amdhsa_kernel
```
